```python
import torch

def _softmax(x, axis=-1):
    return torch.softmax(x, dim=axis)
def _gelu(x):
    return torch.nn.functional.gelu(x, approximate="tanh")
def _silu(x):
    return torch.nn.functional.silu(x)
def _sigmoid(x):
    return torch.sigmoid(x)
def _layernorm(x, axis=-1, eps=1e-5):
    m = x.mean(dim=axis, keepdim=True)
    v = x.var(dim=axis, keepdim=True, unbiased=False)
    return (x - m) / torch.sqrt(v + eps)
def _scatter_add(tgt, idx, src, axis=0):
    return tgt.clone().index_add_(axis, idx, src)
def _segment_sum(src, seg, n):
    out = torch.zeros((n,) + src.shape[1:], dtype=src.dtype)
    return out.index_add_(0, seg, src)
def _pad(x, pw):
    flat = tuple(v for pair in reversed(pw) for v in pair)
    return torch.nn.functional.pad(x, flat)

kernel_name = 'parallel_sum__sliding_block_cached__dense_activation_gelu__decode'

def setup_inputs():

    _w = (lambda a: (lambda t: t.to(torch.bfloat16) if t.is_floating_point() else t)(torch.as_tensor(a)))
    def _A_setup():
        B, Sq, D = 1, 1, 640
        Hq, Hkv, Sk, Dh = 32, 32, 8192, 128
        assert Hq % Hkv == 0, (Hq, Hkv)
        return {
            "x": _w((lambda *s: torch.randn(*s, dtype=torch.bfloat16) * 0.05)(B, Sq, D)),
            "k_cache": _w((lambda *s: torch.randn(*s, dtype=torch.bfloat16) * 3.2)(B, Hkv, Sk, Dh)),
            "v_cache": _w((lambda *s: torch.randn(*s, dtype=torch.bfloat16) * 0.8)(B, Hkv, Sk, Dh)),
            "wq": _w((lambda *s: torch.randn(*s, dtype=torch.bfloat16) * 3.2)(D, Hq * Dh) * (D ** -0.5)),
            "wo": _w((lambda *s: torch.randn(*s, dtype=torch.bfloat16) * 0.8)(Hq * Dh, D) * ((Hq * Dh) ** -0.5)),
        }
    _A_in = _A_setup()

    def _B_setup():
        B, S, D, F = 1, 1, 640, 1728
        return {
            "x": _w((lambda *s: torch.randn(*s, dtype=torch.bfloat16) * 0.05)(B, S, D)),
            "w1": _w((lambda *s: torch.randn(*s, dtype=torch.bfloat16) * 0.8)(D, F) * (D ** -0.5)),
            "b1": _w((lambda *s: torch.randn(*s, dtype=torch.bfloat16) * 0.8)(F) * 0.01),
            "w2": _w((lambda *s: torch.randn(*s, dtype=torch.bfloat16) * 0.8)(F, D) * (F ** -0.5)),
            "b2": _w((lambda *s: torch.randn(*s, dtype=torch.bfloat16) * 0.8)(D) * 0.01),
        }
    _B_in = _B_setup()

    return {
        "A_x": _A_in["x"],
        "A_k_cache": _A_in["k_cache"],
        "A_v_cache": _A_in["v_cache"],
        "A_wq": _A_in["wq"],
        "A_wo": _A_in["wo"],
        "B_x": _B_in["x"],
        "B_w1": _B_in["w1"],
        "B_b1": _B_in["b1"],
        "B_w2": _B_in["w2"],
        "B_b2": _B_in["b2"],
    }

def reference(A_x, A_k_cache, A_v_cache, A_wq, A_wo, B_x, B_w1, B_b1, B_w2, B_b2):
    def _A_ref(x, k_cache, v_cache, wq, wo):
        B, Sq, D = x.shape
        Hq, Dh = 32, 128
        Hkv, Sk = k_cache.shape[1], k_cache.shape[2]
        W = min(4096, max(256, Sk // 4))
        rep = Hq // Hkv
        q = (lambda x, *d: x.permute(*d))((x @ wq).reshape(B, Sq, Hq, Dh), 0, 2, 1, 3)
        k = (lambda x, n, axis: torch.repeat_interleave(x, n, dim=axis))(k_cache[:, :, Sk - W:, :], rep, axis=1)
        v = (lambda x, n, axis: torch.repeat_interleave(x, n, dim=axis))(v_cache[:, :, Sk - W:, :], rep, axis=1)
        scores = torch.einsum("bhqd,bhkd->bhqk", q, k) * (Dh ** -0.5)
        p = _softmax(scores, axis=-1)
        o = torch.einsum("bhqk,bhkd->bhqd", p, v)
        return (lambda x, *d: x.permute(*d))(o, 0, 2, 1, 3).reshape(B, Sq, Hq * Dh) @ wo

    def _B_ref(x, w1, b1, w2, b2):
        h = torch.einsum("bsd,df->bsf", x, w1) + b1
        h = _gelu(h)
        return torch.einsum("bsf,fd->bsd", h, w2) + b2

    x = A_x
    xn = _layernorm(x, axis=-1)
    return x + _A_ref(xn, A_k_cache, A_v_cache, A_wq, A_wo) + _B_ref(xn, B_w1, B_b1, B_w2, B_b2)
```

```asm
; @launch grid=(256,1,1) block=(384,1,1) lds=4864
.amdgcn_target "amdgcn-amd-amdhsa--gfx950"
.text
.globl parallel_sum__sliding_block_cached__dense_activation_gelu__decode_kernel
.p2align 8
.type parallel_sum__sliding_block_cached__dense_activation_gelu__decode_kernel,@function
parallel_sum__sliding_block_cached__dense_activation_gelu__decode_kernel:
    s_load_dwordx16 s[8:23], s[0:1], 0
    s_load_dwordx8 s[24:31], s[0:1], 64
    s_load_dwordx2 s[32:33], s[0:1], 96
    v_lshrrev_b32 v1, 6, v0
    v_and_b32 v0, 63, v0
    v_readfirstlane_b32 s3, v1
    s_cmp_ge_u32 s2, 256
    s_cbranch_scc1 L_end
    s_and_b32 s4, s2, 7
    s_bfe_u32 s5, s2, 0x20003
    s_lshl2_add_u32 s4, s4, s5
    s_lshr_b32 s5, s2, 5
    s_mov_b32 s34, 3145728
    s_mov_b32 s35, 0x20000
    s_cmp_ge_u32 s3, 2
    s_cbranch_scc1 L_stream
    s_setprio 3
    s_getpc_b64 s[52:53]
L_pc:
    v_lshlrev_b32 v1, 7, v0
    v_min_u32 v1, L_codeend-L_pc-4, v1
    global_load_dword v150, v1, s[52:53]
    s_mov_b32 s38, 1280
    s_mov_b32 s39, 0x20000
    s_mov_b32 s43, 0x20000
    s_mov_b32 s47, 0x20000
    s_cmp_lt_u32 s4, 27
    s_cselect_b32 s57, 2211840, 0
    s_cmp_eq_u32 s3, 0
    s_movk_i32 s59, 3456
    s_cselect_b32 s56, 8192, s59
    s_cselect_b32 s42, 5242880, s57
    s_cselect_b32 s46, 5242880, 0
    s_cselect_b32 s50, 1280, s59
    s_cselect_b32 s57, 8, 7
    s_lshl_b32 s57, s4, s57
    s_mul_i32 s58, s5, 80
    s_mul_i32 s58, s58, s56
    s_add_u32 s58, s58, s57
    s_mul_i32 s59, s56, 10
    s_mul_i32 s60, s5, 160
    v_lshrrev_b32 v8, 3, v0
    v_mul_lo_u32 v6, v8, s59
    v_and_b32 v8, 7, v0
    v_lshl_add_u32 v6, v8, 4, v6
    v_lshlrev_b32 v1, 4, v0
    v_lshlrev_b32 v7, 2, v0
    v_lshrrev_b32 v3, 4, v0
    v_bfe_u32 v4, v0, 1, 1
    v_lshl_add_u32 v8, v3, 1, v4
    v_mul_u32_u24 v17, 20, v8
    s_lshl_b32 s64, s5, 9
    s_add_u32 s64, s64, 1015808
    s_lshl_b32 s66, s3, 5
    s_or_b32 s66, s66, s4
    s_cmp_eq_u32 s66, 32
    s_cselect_b32 s67, s64, 0x40000000
    s_lshl_b32 s101, s5, 7
    s_add_u32 s101, s101, 1024000
    s_cmp_eq_u32 s66, 32
    s_cselect_b32 s100, s101, 0x40000000
    v_mov_b32 v28, 0
    v_mov_b32 v29, 0
    v_mov_b32 v30, 0
    v_mov_b32 v31, 0
    s_cmp_eq_u32 s3, 0
    s_waitcnt lgkmcnt(0)
    s_mov_b32 exec_hi, 0
    buffer_store_dwordx4 v[28:31], v1, s[32:35], s67 offen sc1
    s_mov_b32 exec_hi, -1
    s_mov_b64 s[36:37], s[8:9]
    s_cselect_b64 s[40:41], s[14:15], s[20:21]
    s_mov_b64 s[44:45], s[14:15]
    buffer_load_dwordx4 v[12:15], v1, s[36:39], 0 offen
    buffer_load_dword v16, v7, s[36:39], 0 offen offset:1024
    buffer_load_dwordx4 v[18:21], v17, s[36:39], s60 offen
    buffer_load_dword v22, v17, s[36:39], s60 offen offset:16
    buffer_load_dwordx4 v[64:67], v6, s[40:43], s58 offen nt
    buffer_load_dwordx4 v[68:71], v6, s[44:47], s58 offen offset:128 nt
    s_add_u32 s58, s58, s56
    buffer_load_dwordx4 v[72:75], v6, s[40:43], s58 offen nt
    buffer_load_dwordx4 v[76:79], v6, s[44:47], s58 offen offset:128 nt
    s_add_u32 s58, s58, s56
    buffer_load_dwordx4 v[80:83], v6, s[40:43], s58 offen nt
    buffer_load_dwordx4 v[84:87], v6, s[44:47], s58 offen offset:128 nt
    s_add_u32 s58, s58, s56
    buffer_load_dwordx4 v[88:91], v6, s[40:43], s58 offen nt
    buffer_load_dwordx4 v[92:95], v6, s[44:47], s58 offen offset:128 nt
    s_add_u32 s58, s58, s56
    buffer_load_dwordx4 v[96:99], v6, s[40:43], s58 offen nt
    buffer_load_dwordx4 v[100:103], v6, s[44:47], s58 offen offset:128 nt
    s_add_u32 s58, s58, s56
    buffer_load_dwordx4 v[104:107], v6, s[40:43], s58 offen nt
    buffer_load_dwordx4 v[108:111], v6, s[44:47], s58 offen offset:128 nt
    s_add_u32 s58, s58, s56
    buffer_load_dwordx4 v[112:115], v6, s[40:43], s58 offen nt
    buffer_load_dwordx4 v[116:119], v6, s[44:47], s58 offen offset:128 nt
    s_add_u32 s58, s58, s56
    buffer_load_dwordx4 v[120:123], v6, s[40:43], s58 offen nt
    buffer_load_dwordx4 v[124:127], v6, s[44:47], s58 offen offset:128 nt
    s_add_u32 s58, s58, s56
    buffer_load_dwordx4 v[128:131], v6, s[40:43], s58 offen nt
    buffer_load_dwordx4 v[132:135], v6, s[44:47], s58 offen offset:128 nt
    s_add_u32 s58, s58, s56
    buffer_load_dwordx4 v[136:139], v6, s[40:43], s58 offen nt
    buffer_load_dwordx4 v[140:143], v6, s[44:47], s58 offen offset:128 nt
    s_barrier
    s_load_dword s6, s[32:33], 0
    s_cmp_eq_u32 s3, 0
    s_cselect_b64 s[48:49], s[26:27], s[22:23]
    s_mov_b32 s51, 0x20000
    s_mov_b64 s[8:9], s[28:29]
    s_mov_b32 s10, 1280
    s_mov_b32 s11, 0x20000
    v_bfe_u32 v2, v0, 2, 2
    v_and_b32 v5, 1, v0
    v_lshl_add_u32 v10, v2, 1, v5
    v_lshl_add_u32 v9, v8, 4, v10
    v_mov_b32 v147, 0
    v_mov_b32 v62, 0
    s_cbranch_scc1 L_a_extra
    v_lshlrev_b32 v11, 1, v9
    buffer_load_ushort v23, v11, s[48:51], s57 offen
    buffer_load_ushort v144, v11, s[48:51], s57 offen offset:16
    buffer_load_ushort v148, v11, s[48:51], s57 offen
    buffer_load_ushort v149, v11, s[48:51], s57 offen
    s_branch L_extra_done
L_a_extra:
    v_and_b32 v145, 15, v0
    v_mul_u32_u24 v11, 15, v3
    v_add_u32 v11, v11, v145
    v_lshlrev_b32 v62, 1, v11
    s_mov_b32 s61, s60
    buffer_load_ushort v23, v62, s[36:39], s61 offen
    buffer_load_ushort v144, v62, s[48:51], s61 offen
    buffer_load_ushort v148, v62, s[36:39], s61 offen offset:120
    buffer_load_ushort v149, v62, s[48:51], s61 offen offset:120
    v_mov_b32 v146, 0xff800000
    ds_write_b64 v147, v[146:147] offset:4608
L_extra_done:
    v_lshlrev_b32 v60, 4, v5
    v_mov_b32 v61, 0xffff
    v_lshlrev_b32 v61, v60, v61
    v_mov_b32 v56, 0
    v_mov_b32 v57, 0
    v_mov_b32 v58, 0
    v_mov_b32 v59, 0
    s_nop 0
    v_mov_b32_dpp v56, v61 quad_perm:[0,1,2,3] row_mask:0xf bank_mask:0x1
    v_mov_b32_dpp v57, v61 quad_perm:[0,1,2,3] row_mask:0xf bank_mask:0x2
    v_mov_b32_dpp v58, v61 quad_perm:[0,1,2,3] row_mask:0xf bank_mask:0x4
    v_mov_b32_dpp v59, v61 quad_perm:[0,1,2,3] row_mask:0xf bank_mask:0x8
    s_mov_b32 s68, 0xcccccccc
    s_mov_b32 s69, 0xcccccccc
    s_waitcnt vmcnt(26)
    v_lshlrev_b32 v24, 16, v12
    v_and_b32 v25, 0xffff0000, v12
    v_lshlrev_b32 v26, 16, v13
    v_and_b32 v27, 0xffff0000, v13
    v_lshlrev_b32 v28, 16, v14
    v_and_b32 v29, 0xffff0000, v14
    v_lshlrev_b32 v30, 16, v15
    v_and_b32 v31, 0xffff0000, v15
    v_lshlrev_b32 v32, 16, v16
    v_and_b32 v33, 0xffff0000, v16
    v_readfirstlane_b32 s55, v24
    s_nop 1
    v_subrev_f32 v24, s55, v24
    v_subrev_f32 v25, s55, v25
    v_subrev_f32 v26, s55, v26
    v_subrev_f32 v27, s55, v27
    v_subrev_f32 v28, s55, v28
    v_subrev_f32 v29, s55, v29
    v_subrev_f32 v30, s55, v30
    v_subrev_f32 v31, s55, v31
    v_subrev_f32 v32, s55, v32
    v_subrev_f32 v33, s55, v33
    v_add_f32 v34, v24, v25
    v_mul_f32 v35, v24, v24
    v_fmac_f32 v35, v25, v25
    v_add_f32 v34, v34, v26
    v_fmac_f32 v35, v26, v26
    v_add_f32 v34, v34, v27
    v_fmac_f32 v35, v27, v27
    v_add_f32 v34, v34, v28
    v_fmac_f32 v35, v28, v28
    v_add_f32 v34, v34, v29
    v_fmac_f32 v35, v29, v29
    v_add_f32 v34, v34, v30
    v_fmac_f32 v35, v30, v30
    v_add_f32 v34, v34, v31
    v_fmac_f32 v35, v31, v31
    v_add_f32 v34, v34, v32
    v_fmac_f32 v35, v32, v32
    v_add_f32 v34, v34, v33
    v_fmac_f32 v35, v33, v33
    s_nop 0
    v_add_f32_dpp v34, v34, v34 quad_perm:[1,0,3,2] row_mask:0xf bank_mask:0xf
    v_add_f32_dpp v35, v35, v35 quad_perm:[1,0,3,2] row_mask:0xf bank_mask:0xf
    s_nop 0
    v_add_f32_dpp v34, v34, v34 quad_perm:[2,3,0,1] row_mask:0xf bank_mask:0xf
    v_add_f32_dpp v35, v35, v35 quad_perm:[2,3,0,1] row_mask:0xf bank_mask:0xf
    s_nop 0
    v_add_f32_dpp v34, v34, v34 row_half_mirror row_mask:0xf bank_mask:0xf
    v_add_f32_dpp v35, v35, v35 row_half_mirror row_mask:0xf bank_mask:0xf
    s_nop 0
    v_add_f32_dpp v34, v34, v34 row_mirror row_mask:0xf bank_mask:0xf
    v_add_f32_dpp v35, v35, v35 row_mirror row_mask:0xf bank_mask:0xf
    v_mov_b32 v36, v34
    v_mov_b32 v37, v35
    s_nop 1
    v_permlane16_swap_b32 v34, v36
    v_permlane16_swap_b32 v35, v37
    s_nop 0
    v_add_f32 v34, v34, v36
    v_add_f32 v35, v35, v37
    v_mov_b32 v36, v34
    v_mov_b32 v37, v35
    s_nop 1
    v_permlane32_swap_b32 v34, v36
    v_permlane32_swap_b32 v35, v37
    s_nop 0
    v_add_f32 v34, v34, v36
    v_add_f32 v35, v35, v37
    v_mul_f32 v34, 0x3acccccd, v34
    v_mul_f32 v35, 0x3acccccd, v35
    v_fma_f32 v35, -v34, v34, v35
    v_max_f32 v35, 0, v35
    v_add_f32 v34, s55, v34
    v_cvt_pk_bf16_f32 v34, v34, v35
    v_and_b32 v35, 0xffff0000, v34
    v_lshlrev_b32 v34, 16, v34
    v_add_f32 v35, 0x3727c5ac, v35
    v_cvt_pk_bf16_f32 v35, v35, v35
    v_and_b32 v35, 0xffff0000, v35
    v_sqrt_f32 v35, v35
    s_waitcnt vmcnt(24)
    v_cvt_pk_bf16_f32 v35, v35, v35
    v_and_b32 v35, 0xffff0000, v35
    v_rcp_f32 v35, v35
    v_lshlrev_b32 v36, 16, v18
    v_and_b32 v37, 0xffff0000, v18
    v_sub_f32 v36, v36, v34
    v_sub_f32 v37, v37, v34
    v_cvt_pk_bf16_f32 v36, v36, v37
    v_and_b32 v37, 0xffff0000, v36
    v_lshlrev_b32 v36, 16, v36
    v_mul_f32 v36, v36, v35
    v_mul_f32 v37, v37, v35
    v_cvt_pk_bf16_f32 v36, v36, v36
    v_cvt_pk_bf16_f32 v37, v37, v37
    v_and_b32 v24, v36, v56
    v_and_b32 v25, v36, v57
    v_and_b32 v26, v36, v58
    v_and_b32 v27, v36, v59
    v_and_b32 v28, v37, v56
    v_and_b32 v29, v37, v57
    v_and_b32 v30, v37, v58
    v_and_b32 v31, v37, v59
    s_waitcnt vmcnt(23)
    v_mfma_f32_16x16x32_bf16 v[48:51], v[64:67], v[24:27], 0
    s_waitcnt vmcnt(22)
    v_mfma_f32_16x16x32_bf16 v[52:55], v[68:71], v[24:27], 0
    s_waitcnt vmcnt(21)
    v_mfma_f32_16x16x32_bf16 v[48:51], v[72:75], v[28:31], v[48:51]
    s_waitcnt vmcnt(20)
    v_mfma_f32_16x16x32_bf16 v[52:55], v[76:79], v[28:31], v[52:55]
    v_lshlrev_b32 v36, 16, v19
    v_and_b32 v37, 0xffff0000, v19
    v_sub_f32 v36, v36, v34
    v_sub_f32 v37, v37, v34
    v_cvt_pk_bf16_f32 v36, v36, v37
    v_and_b32 v37, 0xffff0000, v36
    v_lshlrev_b32 v36, 16, v36
    v_mul_f32 v36, v36, v35
    v_mul_f32 v37, v37, v35
    v_cvt_pk_bf16_f32 v36, v36, v36
    v_cvt_pk_bf16_f32 v37, v37, v37
    v_and_b32 v40, v36, v56
    v_and_b32 v41, v36, v57
    v_and_b32 v42, v36, v58
    v_and_b32 v43, v36, v59
    v_and_b32 v44, v37, v56
    v_and_b32 v45, v37, v57
    v_and_b32 v46, v37, v58
    v_and_b32 v47, v37, v59
    s_waitcnt vmcnt(19)
    v_mfma_f32_16x16x32_bf16 v[48:51], v[80:83], v[40:43], v[48:51]
    s_waitcnt vmcnt(18)
    v_mfma_f32_16x16x32_bf16 v[52:55], v[84:87], v[40:43], v[52:55]
    s_waitcnt vmcnt(17)
    v_mfma_f32_16x16x32_bf16 v[48:51], v[88:91], v[44:47], v[48:51]
    s_waitcnt vmcnt(16)
    v_mfma_f32_16x16x32_bf16 v[52:55], v[92:95], v[44:47], v[52:55]
    v_lshlrev_b32 v36, 16, v20
    v_and_b32 v37, 0xffff0000, v20
    v_sub_f32 v36, v36, v34
    v_sub_f32 v37, v37, v34
    v_cvt_pk_bf16_f32 v36, v36, v37
    v_and_b32 v37, 0xffff0000, v36
    v_lshlrev_b32 v36, 16, v36
    v_mul_f32 v36, v36, v35
    v_mul_f32 v37, v37, v35
    v_cvt_pk_bf16_f32 v36, v36, v36
    v_cvt_pk_bf16_f32 v37, v37, v37
    v_and_b32 v24, v36, v56
    v_and_b32 v25, v36, v57
    v_and_b32 v26, v36, v58
    v_and_b32 v27, v36, v59
    v_and_b32 v28, v37, v56
    v_and_b32 v29, v37, v57
    v_and_b32 v30, v37, v58
    v_and_b32 v31, v37, v59
    s_waitcnt vmcnt(15)
    v_mfma_f32_16x16x32_bf16 v[48:51], v[96:99], v[24:27], v[48:51]
    s_waitcnt vmcnt(14)
    v_mfma_f32_16x16x32_bf16 v[52:55], v[100:103], v[24:27], v[52:55]
    s_waitcnt vmcnt(13)
    v_mfma_f32_16x16x32_bf16 v[48:51], v[104:107], v[28:31], v[48:51]
    s_waitcnt vmcnt(12)
    v_mfma_f32_16x16x32_bf16 v[52:55], v[108:111], v[28:31], v[52:55]
    v_lshlrev_b32 v36, 16, v21
    v_and_b32 v37, 0xffff0000, v21
    v_sub_f32 v36, v36, v34
    v_sub_f32 v37, v37, v34
    v_cvt_pk_bf16_f32 v36, v36, v37
    v_and_b32 v37, 0xffff0000, v36
    v_lshlrev_b32 v36, 16, v36
    v_mul_f32 v36, v36, v35
    v_mul_f32 v37, v37, v35
    v_cvt_pk_bf16_f32 v36, v36, v36
    v_cvt_pk_bf16_f32 v37, v37, v37
    v_and_b32 v40, v36, v56
    v_and_b32 v41, v36, v57
    v_and_b32 v42, v36, v58
    v_and_b32 v43, v36, v59
    v_and_b32 v44, v37, v56
    v_and_b32 v45, v37, v57
    v_and_b32 v46, v37, v58
    v_and_b32 v47, v37, v59
    s_waitcnt vmcnt(11)
    v_mfma_f32_16x16x32_bf16 v[48:51], v[112:115], v[40:43], v[48:51]
    s_waitcnt vmcnt(10)
    v_mfma_f32_16x16x32_bf16 v[52:55], v[116:119], v[40:43], v[52:55]
    s_waitcnt vmcnt(9)
    v_mfma_f32_16x16x32_bf16 v[48:51], v[120:123], v[44:47], v[48:51]
    s_waitcnt vmcnt(8)
    v_mfma_f32_16x16x32_bf16 v[52:55], v[124:127], v[44:47], v[52:55]
    v_lshlrev_b32 v36, 16, v22
    v_and_b32 v37, 0xffff0000, v22
    v_sub_f32 v36, v36, v34
    v_sub_f32 v37, v37, v34
    v_cvt_pk_bf16_f32 v36, v36, v37
    v_and_b32 v37, 0xffff0000, v36
    v_lshlrev_b32 v36, 16, v36
    v_mul_f32 v36, v36, v35
    v_mul_f32 v37, v37, v35
    v_cvt_pk_bf16_f32 v36, v36, v36
    v_cvt_pk_bf16_f32 v37, v37, v37
    v_and_b32 v24, v36, v56
    v_and_b32 v25, v36, v57
    v_and_b32 v26, v36, v58
    v_and_b32 v27, v36, v59
    v_and_b32 v28, v37, v56
    v_and_b32 v29, v37, v57
    v_and_b32 v30, v37, v58
    v_and_b32 v31, v37, v59
    s_waitcnt vmcnt(7)
    v_mfma_f32_16x16x32_bf16 v[48:51], v[128:131], v[24:27], v[48:51]
    s_waitcnt vmcnt(6)
    v_mfma_f32_16x16x32_bf16 v[52:55], v[132:135], v[24:27], v[52:55]
    s_waitcnt vmcnt(5)
    v_mfma_f32_16x16x32_bf16 v[48:51], v[136:139], v[28:31], v[48:51]
    s_waitcnt vmcnt(4)
    v_mfma_f32_16x16x32_bf16 v[52:55], v[140:143], v[28:31], v[52:55]
    s_waitcnt lgkmcnt(0)
    s_mul_i32 s6, s6, 1664525
    s_add_u32 s6, s6, 1013904223
    s_lshl_b32 s56, s4, 13
    s_lshl_b32 s57, s5, 10
    s_mul_i32 s58, s3, 262144
    s_add_u32 s58, s58, s56
    s_add_u32 s58, s58, 4096
    s_add_u32 s60, s58, s57
    s_add_u32 s59, s58, 4096
    v_mov_b32 v41, s6
    v_mov_b32 v43, s6
    v_permlane32_swap_b32 v48, v52
    v_permlane32_swap_b32 v49, v53
    v_permlane32_swap_b32 v50, v54
    v_permlane32_swap_b32 v51, v55
    s_nop 0
    v_add_f32_dpp v48, v52, v48 quad_perm:[2,3,0,1] row_mask:0xf bank_mask:0xf
    v_add_f32_dpp v49, v53, v49 quad_perm:[2,3,0,1] row_mask:0xf bank_mask:0xf
    v_add_f32_dpp v50, v50, v54 quad_perm:[2,3,0,1] row_mask:0xf bank_mask:0xf
    v_add_f32_dpp v51, v51, v55 quad_perm:[2,3,0,1] row_mask:0xf bank_mask:0xf
    s_cmp_eq_u32 s3, 0
    s_cselect_b32 s67, -1, 0
    s_mov_b32 s66, -1
    v_cndmask_b32 v40, v48, v50, s[68:69]
    v_cndmask_b32 v42, v49, v51, s[68:69]
    s_mov_b64 exec, s[66:67]
    buffer_store_dwordx4 v[40:43], v1, s[32:35], s60 offen sc1
    s_mov_b64 exec, 1
    buffer_store_dword v41, v147, s[32:35], s100 offen sc1
    s_mov_b64 exec, s[66:67]
    s_barrier
    s_mov_b32 s7, s6
    s_lshl_b32 s55, s3, 9
    s_sub_u32 s55, 1020, s55
    s_add_u32 s55, s55, s58
    s_add_u32 s52, s32, s55
    s_addc_u32 s53, s33, 0
    s_mov_b32 s54, 16
L_sp:
    s_load_dword s16, s[52:53], 0 glc
    s_load_dword s17, s[52:53], 1024 glc
    s_load_dword s18, s[52:53], 2048 glc
    s_load_dword s19, s[52:53], 3072 glc
    s_load_dword s20, s[52:53], 4096 glc
    s_load_dword s21, s[52:53], 5120 glc
    s_load_dword s22, s[52:53], 6144 glc
    s_load_dword s23, s[52:53], 7168 glc
    s_add_u32 s54, s54, 1
    s_cmp_gt_u32 s54, 100000
    s_waitcnt lgkmcnt(0)
    s_cbranch_scc1 L_spd
    s_cmp_eq_u64 s[16:17], s[6:7]
    s_cbranch_scc0 L_sp
    s_cmp_eq_u64 s[18:19], s[6:7]
    s_cbranch_scc0 L_sp
    s_cmp_eq_u64 s[20:21], s[6:7]
    s_cbranch_scc0 L_sp
    s_cmp_eq_u64 s[22:23], s[6:7]
    s_cbranch_scc0 L_sp
L_spd:
    s_mov_b32 s7, 0
L_poll0:
    buffer_load_dwordx4 v[64:67], v1, s[32:35], s58 offen offset:0 sc1
    buffer_load_dwordx4 v[68:71], v1, s[32:35], s58 offen offset:1024 sc1
    buffer_load_dwordx4 v[72:75], v1, s[32:35], s58 offen offset:2048 sc1
    buffer_load_dwordx4 v[76:79], v1, s[32:35], s58 offen offset:3072 sc1
    buffer_load_dwordx4 v[80:83], v1, s[32:35], s59 offen offset:0 sc1
    buffer_load_dwordx4 v[84:87], v1, s[32:35], s59 offen offset:1024 sc1
    buffer_load_dwordx4 v[88:91], v1, s[32:35], s59 offen offset:2048 sc1
    buffer_load_dwordx4 v[92:95], v1, s[32:35], s59 offen offset:3072 sc1
    s_cmp_lg_u32 s7, 0
    s_cbranch_scc1 L_nf0
    s_barrier
L_nf0:
    s_add_u32 s7, s7, 1
    s_waitcnt vmcnt(7)
    v_cmpx_eq_u32 vcc, s6, v65
    v_cmpx_eq_u32 vcc, s6, v67
    s_waitcnt vmcnt(6)
    v_cmpx_eq_u32 vcc, s6, v69
    v_cmpx_eq_u32 vcc, s6, v71
    s_waitcnt vmcnt(5)
    v_cmpx_eq_u32 vcc, s6, v73
    v_cmpx_eq_u32 vcc, s6, v75
    s_waitcnt vmcnt(4)
    v_cmpx_eq_u32 vcc, s6, v77
    v_cmpx_eq_u32 vcc, s6, v79
    s_waitcnt vmcnt(3)
    v_cmpx_eq_u32 vcc, s6, v81
    v_cmpx_eq_u32 vcc, s6, v83
    s_waitcnt vmcnt(2)
    v_cmpx_eq_u32 vcc, s6, v85
    v_cmpx_eq_u32 vcc, s6, v87
    s_waitcnt vmcnt(1)
    v_cmpx_eq_u32 vcc, s6, v89
    v_cmpx_eq_u32 vcc, s6, v91
    s_waitcnt vmcnt(0)
    v_cmpx_eq_u32 vcc, s6, v93
    v_cmpx_eq_u32 vcc, s6, v95
    s_nop 1
    s_cmp_eq_u64 exec, s[66:67]
    s_mov_b64 exec, s[66:67]
    s_cbranch_scc1 L_polldone0
    s_cmp_lt_u32 s7, 100000
    s_cbranch_scc1 L_poll0
    s_endpgm
L_polldone0:
    v_add_f32 v64, v64, v68
    v_add_f32 v66, v66, v70
    v_add_f32 v64, v64, v72
    v_add_f32 v66, v66, v74
    v_add_f32 v64, v64, v76
    v_add_f32 v66, v66, v78
    v_add_f32 v64, v64, v80
    v_add_f32 v66, v66, v82
    v_add_f32 v64, v64, v84
    v_add_f32 v66, v66, v86
    v_add_f32 v64, v64, v88
    v_add_f32 v66, v66, v90
    v_add_f32 v64, v64, v92
    v_add_f32 v66, v66, v94
    v_cvt_pk_bf16_f32 v48, v64, v66
    s_cmp_eq_u32 s3, 0
    s_cbranch_scc1 L_a
    v_and_b32 v49, 0xffff0000, v48
    v_lshlrev_b32 v48, 16, v48
    v_lshlrev_b32 v50, 16, v23
    v_lshlrev_b32 v51, 16, v144
    v_add_f32 v48, v48, v50
    v_add_f32 v49, v49, v51
    v_cvt_pk_bf16_f32 v48, v48, v49
    v_and_b32 v49, 0xffff0000, v48
    v_lshlrev_b32 v48, 16, v48
    s_mov_b32 s62, 0xbdd2d3e8
    v_mov_b32 v52, 0xc0135761
    v_mul_f32 v50, v48, v48
    v_mul_f32 v51, v49, v49
    v_fma_f32 v50, v50, s62, v52
    v_fma_f32 v51, v51, s62, v52
    v_mul_f32 v50, v50, v48
    v_mul_f32 v51, v51, v49
    v_exp_f32 v50, v50
    v_exp_f32 v51, v51
    v_lshlrev_b32 v9, 2, v9
    v_add_f32 v50, 1.0, v50
    v_add_f32 v51, 1.0, v51
    v_rcp_f32 v50, v50
    v_rcp_f32 v51, v51
    s_nop 0
    v_mul_f32 v48, v48, v50
    v_mul_f32 v49, v49, v51
    v_cvt_pk_bf16_f32 v48, v48, v48
    v_cvt_pk_bf16_f32 v49, v49, v49
    v_add_u32 v9, 4352, v9
    ds_write2_b32 v9, v48, v49 offset0:0 offset1:8
    s_waitcnt lgkmcnt(0)
    s_barrier
    s_endpgm
L_a:
    v_lshlrev_b32 v12, 1, v9
    ds_write_b16 v12, v48 offset:4096
    ds_write_b16_d16_hi v12, v48 offset:4112
    s_waitcnt lgkmcnt(0)
    s_barrier
    v_lshl_add_u32 v12, v3, 3, v10
    v_lshl_add_u32 v12, v12, 1, v4
    v_lshlrev_b32 v13, 3, v12
    v_add_u32 v14, 32, v10
    v_cmp_gt_u32 vcc, 32, v0
    v_lshl_add_u32 v15, v8, 3, v10
    v_lshlrev_b32 v15, 4, v15
    v_lshrrev_b32 v12, 5, v15
    v_and_b32 v14, 16, v15
    v_lshl_add_u32 v12, v12, 10, v14
    s_add_u32 s60, s56, 532480
    s_add_u32 s60, s60, s57
    s_add_u32 s55, s56, s57
    s_lshr_b32 s55, s55, 6
    s_add_u32 s55, s55, 528384
    s_add_u32 s20, s60, 1048576
    s_add_u32 s21, s55, 1048576
    v_add_u32 v50, 0, v11
    v_lshrrev_b32 v51, 5, v50
    v_and_b32 v52, 7, v50
    v_lshl_add_u32 v51, v51, 3, v52
    v_bfe_u32 v52, v50, 3, 2
    v_lshl_add_u32 v51, v51, 2, v52
    v_lshlrev_b32 v12, 2, v51
    v_add_u32 v50, 60, v11
    v_lshrrev_b32 v51, 5, v50
    v_and_b32 v52, 7, v50
    v_lshl_add_u32 v51, v51, 3, v52
    v_bfe_u32 v52, v50, 3, 2
    v_lshl_add_u32 v51, v51, 2, v52
    v_lshlrev_b32 v14, 2, v51
    v_lshlrev_b32 v148, 16, v148
    v_lshlrev_b32 v149, 16, v149
    v_add_f32 v148, v148, v149
    s_mov_b32 s62, 0x80008000
    s_mov_b32 s63, 0x80008000
    s_mov_b32 s22, 0x7fff7fff
    s_mov_b32 s23, 0x7fff7fff
    s_mov_b32 s24, 0x001f7fff
    s_mov_b32 s25, 0
    s_mov_b32 s26, 0x41f80000
    s_mov_b32 s66, -1
    s_mov_b32 s67, 0x3333
    s_mov_b32 s68, 0xaaaaaaaa
    s_mov_b32 s69, 0xaaaaaaaa
    v_mov_b32 v45, s6
    v_mov_b32 v47, s6
    v_lshlrev_b32 v23, 16, v23
    v_lshlrev_b32 v144, 16, v144
    v_add_f32 v23, v23, v144
    s_barrier
    s_add_u32 s52, s32, s101
    s_addc_u32 s53, s33, 0
    s_mov_b32 s54, 0
L_zf:
    s_load_dword s16, s[52:53], 0 glc
    s_add_u32 s54, s54, 1
    s_cmp_gt_u32 s54, 100000
    s_cbranch_scc1 L_end
    s_waitcnt lgkmcnt(0)
    s_cmp_eq_u32 s16, s6
    s_cbranch_scc0 L_zf
    s_barrier
    ds_read_b64 v[48:49], v147 offset:4608
    ds_read_b64 v[24:25], v13 offset:0
    ds_read_b64 v[26:27], v13 offset:512
    ds_read_b64 v[28:29], v13 offset:1024
    ds_read_b64 v[30:31], v13 offset:1536
    s_waitcnt lgkmcnt(2)
    v_pk_add_f32 v[24:25], v[24:25], v[26:27]
    s_waitcnt lgkmcnt(0)
    v_pk_add_f32 v[28:29], v[28:29], v[30:31]
    v_add_f32 v40, v24, v28
    v_add_f32 v42, v25, v29
    v_mov_b32 v44, v48
    v_mov_b32 v46, v49
    buffer_store_dwordx4 v[40:43], v15, s[32:35], s20 offen
    s_mov_b64 exec, 1
    buffer_store_dwordx4 v[44:47], v147, s[32:35], s21 offen
    s_mov_b64 exec, -1
    buffer_store_dwordx4 v[40:43], v15, s[32:35], s60 offen sc1
    s_mov_b64 exec, 1
    buffer_store_dwordx4 v[44:47], v147, s[32:35], s55 offen sc1
    s_mov_b64 exec, -1
    s_barrier
    s_barrier
    ds_read2st64_b32 v[24:25], v12 offset0:8 offset1:10
    ds_read2st64_b32 v[26:27], v12 offset0:12 offset1:14
    ds_read2st64_b32 v[28:29], v14 offset0:8 offset1:10
    ds_read2st64_b32 v[30:31], v14 offset0:12 offset1:14
    s_waitcnt lgkmcnt(2)
    v_pk_add_f32 v[24:25], v[24:25], v[26:27]
    v_add_f32 v24, v24, v25
    v_cndmask_b32 v32, v24, 1.0, s[62:63]
    buffer_atomic_add_f32 v32, v7, s[32:35], s64 offen sc0 sc1
    s_waitcnt lgkmcnt(0)
    v_pk_add_f32 v[28:29], v[28:29], v[30:31]
    v_add_f32 v28, v28, v29
    v_cndmask_b32 v33, v28, 1.0, s[62:63]
    s_mov_b32 exec_hi, 0
    buffer_atomic_add_f32 v33, v7, s[32:35], s64 offen offset:256 sc0 sc1
    s_mov_b32 exec_hi, -1
    v_add_f32 v24, v24, v23
    v_add_f32 v28, v28, v148
    s_waitcnt vmcnt(1)
    v_mov_b32_dpp v34, v32 row_newbcast:15 row_mask:0xf bank_mask:0xf
    v_add_f32 v24, v24, v32
    v_cvt_pk_bf16_f32 v24, v24, v24
    v_cmp_eq_u32 vcc, s26, v34
    s_waitcnt vmcnt(0)
    v_mov_b32_dpp v34, v33 row_newbcast:15 row_mask:0xf bank_mask:0xf
    v_add_f32 v28, v28, v33
    v_cvt_pk_bf16_f32 v28, v28, v28
    v_cmp_eq_u32 s[16:17], s26, v34
    s_and_b64 exec, vcc, s[22:23]
    s_mov_b32 s27, exec_lo
    s_cbranch_execz L_a4b
    buffer_store_short v24, v62, s[8:11], s61 offen
L_a4b:
    s_and_b64 exec, s[16:17], s[24:25]
    s_cbranch_execz L_a4c
    buffer_store_short v28, v62, s[8:11], s61 offen offset:120
L_a4c:
    s_and_b32 s27, s27, 1
    s_lshl_b32 s28, s5, 1
    s_or_b32 s27, s27, s28
    s_cmp_lg_u32 s27, 1
    s_cbranch_scc1 L_aend
    s_mov_b64 exec, 1
    buffer_store_dword v41, v147, s[32:35], 0 offen offset:0 sc1
L_aend:
L_end:
    s_endpgm
L_stream:
    s_setprio 2
    s_sub_u32 s3, s3, 2
    s_lshl_b32 s58, s4, 21
    s_lshl_b32 s53, s5, 12
    s_add_u32 s58, s58, s53
    s_lshl_b32 s53, s3, 10
    s_add_u32 s58, s58, s53
    s_add_u32 s58, s58, 1572864
    s_mov_b32 s59, s58
    v_bfe_u32 v8, v0, 2, 2
    v_lshrrev_b32 v9, 4, v0
    v_and_b32 v10, 3, v0
    v_lshlrev_b32 v1, 8, v8
    v_lshl_add_u32 v1, v9, 6, v1
    v_lshl_add_u32 v1, v10, 4, v1
    v_lshlrev_b32 v2, 4, v0
    s_mov_b32 s38, 0x4000000
    s_mov_b32 s39, 0x20000
    s_mov_b32 s42, 0x4000000
    s_mov_b32 s43, 0x20000
    s_waitcnt lgkmcnt(0)
    s_mov_b64 s[36:37], s[10:11]
    s_mov_b64 s[40:41], s[12:13]
    s_load_dword s6, s[32:33], 0
    s_barrier
    buffer_load_dwordx4 v[24:27], v1, s[36:39], s58 offen nt
    s_add_u32 s58, s58, 32768
    buffer_load_dwordx4 v[28:31], v1, s[36:39], s58 offen nt
    s_add_u32 s58, s58, 32768
    buffer_load_dwordx4 v[32:35], v1, s[36:39], s58 offen nt
    s_add_u32 s58, s58, 32768
    buffer_load_dwordx4 v[36:39], v1, s[36:39], s58 offen nt
    s_add_u32 s58, s58, 32768
    buffer_load_dwordx4 v[40:43], v1, s[36:39], s58 offen nt
    s_add_u32 s58, s58, 32768
    buffer_load_dwordx4 v[44:47], v1, s[36:39], s58 offen nt
    s_add_u32 s58, s58, 32768
    buffer_load_dwordx4 v[48:51], v1, s[36:39], s58 offen nt
    s_add_u32 s58, s58, 32768
    buffer_load_dwordx4 v[52:55], v1, s[36:39], s58 offen nt
    s_add_u32 s58, s58, 32768
    s_mov_b64 s[44:45], s[16:17]
    s_mov_b64 s[48:49], s[24:25]
    s_mov_b32 s46, 5242880
    s_mov_b32 s47, 0x20000
    s_mov_b32 s50, 2211840
    s_mov_b32 s51, 0x20000
    s_lshl_b32 s52, s4, 7
    s_lshl_b32 s53, s3, 5
    s_add_u32 s52, s52, s53
    s_mul_i32 s62, s52, 1280
    s_mul_i32 s53, s5, 160
    s_add_u32 s62, s62, s53
    s_lshr_b32 s52, s52, 1
    s_mul_i32 s63, s52, 1280
    s_add_u32 s63, s63, s53
    s_lshl_b32 s64, s4, 13
    s_lshl_b32 s53, s3, 8
    s_add_u32 s64, s64, s53
    s_add_u32 s64, s64, 1581056
    s_lshl_b32 s65, s4, 7
    s_add_u32 s65, s65, 1576960
    v_and_b32 v11, 15, v0
    v_mul_u32_u24 v3, 1280, v9
    v_lshl_add_u32 v3, v11, 4, v3
    v_cmp_lt_u32 vcc, 9, v11
    v_bfrev_b32 v12, 2
    v_and_b32 v11, 1, v0
    v_cndmask_b32 v3, v3, v12, vcc
    v_lshlrev_b32 v12, 4, v11
    v_mov_b32 v13, 0xffff
    v_lshlrev_b32 v13, v12, v13
    v_mov_b32 v4, 0
    v_mov_b32 v5, 0
    v_mov_b32 v6, 0
    v_mov_b32 v7, 0
    s_nop 0
    v_mov_b32_dpp v4, v13 quad_perm:[0,1,2,3] row_mask:0xf bank_mask:0x1
    v_mov_b32_dpp v5, v13 quad_perm:[0,1,2,3] row_mask:0xf bank_mask:0x2
    v_mov_b32_dpp v6, v13 quad_perm:[0,1,2,3] row_mask:0xf bank_mask:0x4
    v_mov_b32_dpp v7, v13 quad_perm:[0,1,2,3] row_mask:0xf bank_mask:0x8
    v_lshl_add_u32 v20, v8, 1, v11
    v_lshl_add_u32 v16, v9, 3, v20
    s_lshl_b32 s53, s3, 5
    v_add_lshl_u32 v16, v16, s53, 4
    v_bfe_u32 v12, v0, 1, 1
    v_lshl_add_u32 v18, v12, 2, v9
    v_lshl_add_u32 v19, v20, 6, v18
    v_lshlrev_b32 v19, 4, v19
    v_lshlrev_b32 v20, 4, v20
    s_lshl_b32 s53, s3, 4
    v_add_lshl_u32 v18, v18, s53, 2
    v_lshl_add_u32 v17, v9, 2, v10
    v_lshlrev_b32 v17, 4, v17
    v_mov_b32 v152, 0
    v_mov_b32 v153, 0
    v_mov_b32 v154, 0
    v_mov_b32 v155, 0
    v_mov_b32 v156, 0
    v_mov_b32 v157, 0
    v_mov_b32 v158, 0
    v_mov_b32 v159, 0
    v_mov_b32 v160, 0
    v_mov_b32 v161, 0
    v_mov_b32 v162, 0
    v_mov_b32 v163, 0
    v_mov_b32 v164, 0
    v_mov_b32 v165, 0
    v_mov_b32 v166, 0
    v_mov_b32 v167, 0
    v_mov_b32 v15, 0
    s_mov_b32 s68, 0xcccccccc
    s_mov_b32 s69, 0xcccccccc
    s_mov_b32 s70, 0x33333333
    s_mov_b32 s71, 0x33333333
    s_mov_b32 s56, 0x00010001
    s_mov_b32 s57, 0x00010001
    s_mov_b32 s66, 0xaaaaaaaa
    s_mov_b32 s67, 0xaaaaaaaa
    s_waitcnt lgkmcnt(0)
    s_mul_i32 s6, s6, 1664525
    s_add_u32 s6, s6, 1013904223
    s_barrier
    buffer_load_dwordx4 v[56:59], v1, s[36:39], s58 offen nt
    s_add_u32 s58, s58, 32768
    buffer_load_dwordx4 v[60:63], v1, s[36:39], s58 offen nt
    s_add_u32 s58, s58, 32768
    buffer_load_dwordx4 v[64:67], v1, s[36:39], s58 offen nt
    s_add_u32 s58, s58, 32768
    buffer_load_dwordx4 v[68:71], v1, s[36:39], s58 offen nt
    s_add_u32 s58, s58, 32768
    buffer_load_dwordx4 v[72:75], v1, s[36:39], s58 offen nt
    s_add_u32 s58, s58, 32768
    buffer_load_dwordx4 v[76:79], v1, s[36:39], s58 offen nt
    s_add_u32 s58, s58, 32768
    buffer_load_dwordx4 v[80:83], v1, s[36:39], s58 offen nt
    s_add_u32 s58, s58, 32768
    buffer_load_dwordx4 v[84:87], v1, s[36:39], s58 offen nt
    s_barrier
    buffer_load_dwordx4 v[88:91], v2, s[40:43], s59 offen nt
    s_add_u32 s59, s59, 32768
    buffer_load_dwordx4 v[92:95], v2, s[40:43], s59 offen nt
    s_add_u32 s59, s59, 32768
    buffer_load_dwordx4 v[96:99], v2, s[40:43], s59 offen nt
    s_add_u32 s59, s59, 32768
    buffer_load_dwordx4 v[100:103], v2, s[40:43], s59 offen nt
    s_add_u32 s59, s59, 32768
    buffer_load_dwordx4 v[104:107], v2, s[40:43], s59 offen nt
    s_add_u32 s59, s59, 32768
    buffer_load_dwordx4 v[108:111], v2, s[40:43], s59 offen nt
    s_add_u32 s59, s59, 32768
    buffer_load_dwordx4 v[112:115], v2, s[40:43], s59 offen nt
    s_add_u32 s59, s59, 32768
    buffer_load_dwordx4 v[116:119], v2, s[40:43], s59 offen nt
    s_add_u32 s59, s59, 32768
    s_barrier
    s_mov_b32 exec_lo, 0xf000f
    s_mov_b32 exec_hi, 0xf000f
    ds_read_b128 v[152:155], v17 offset:4096
    s_mov_b32 exec_lo, 0xf000f0
    s_mov_b32 exec_hi, 0xf000f0
    ds_read_b128 v[156:159], v17 offset:4096
    s_mov_b32 exec_lo, 0xf000f00
    s_mov_b32 exec_hi, 0xf000f00
    ds_read_b128 v[160:163], v17 offset:4096
    s_mov_b32 exec_lo, 0xf000f000
    s_mov_b32 exec_hi, 0xf000f000
    ds_read_b128 v[164:167], v17 offset:4096
    s_mov_b64 exec, -1
    ds_read_b32 v13, v18 offset:4352
    ds_read_b32 v14, v18 offset:4384
    s_waitcnt lgkmcnt(0)
    s_waitcnt vmcnt(20)
    v_mfma_f32_16x16x32_bf16 v[168:171], v[24:27], v[152:155], 0
    v_mfma_f32_16x16x32_bf16 v[168:171], v[28:31], v[156:159], v[168:171]
    v_mfma_f32_16x16x32_bf16 v[168:171], v[32:35], v[160:163], v[168:171]
    v_mfma_f32_16x16x32_bf16 v[168:171], v[36:39], v[164:167], v[168:171]
    s_waitcnt vmcnt(16)
    v_mfma_f32_16x16x32_bf16 v[172:175], v[40:43], v[152:155], 0
    v_mfma_f32_16x16x32_bf16 v[172:175], v[44:47], v[156:159], v[172:175]
    v_mfma_f32_16x16x32_bf16 v[172:175], v[48:51], v[160:163], v[172:175]
    v_mfma_f32_16x16x32_bf16 v[172:175], v[52:55], v[164:167], v[172:175]
    s_waitcnt vmcnt(12)
    v_mfma_f32_16x16x32_bf16 v[176:179], v[56:59], v[152:155], 0
    v_mfma_f32_16x16x32_bf16 v[176:179], v[60:63], v[156:159], v[176:179]
    v_mfma_f32_16x16x32_bf16 v[176:179], v[64:67], v[160:163], v[176:179]
    v_mfma_f32_16x16x32_bf16 v[176:179], v[68:71], v[164:167], v[176:179]
    s_waitcnt vmcnt(8)
    v_mfma_f32_16x16x32_bf16 v[180:183], v[72:75], v[152:155], 0
    v_mfma_f32_16x16x32_bf16 v[180:183], v[76:79], v[156:159], v[180:183]
    v_mfma_f32_16x16x32_bf16 v[180:183], v[80:83], v[160:163], v[180:183]
    v_mfma_f32_16x16x32_bf16 v[180:183], v[84:87], v[164:167], v[180:183]
    v_and_b32 v184, v13, v4
    v_and_b32 v185, v13, v5
    v_and_b32 v186, v13, v6
    v_and_b32 v187, v13, v7
    v_and_b32 v188, v14, v4
    v_and_b32 v189, v14, v5
    v_and_b32 v190, v14, v6
    v_and_b32 v191, v14, v7
    v_mov_b32_dpp v8, v168 quad_perm:[0,0,0,0] row_mask:0xf bank_mask:0xf
    v_mov_b32_dpp v9, v172 quad_perm:[0,0,0,0] row_mask:0xf bank_mask:0xf
    v_mov_b32_dpp v10, v176 quad_perm:[0,0,0,0] row_mask:0xf bank_mask:0xf
    v_mov_b32_dpp v11, v180 quad_perm:[0,0,0,0] row_mask:0xf bank_mask:0xf
    v_add_f32_dpp v8, v169, v8 quad_perm:[1,1,1,1] row_mask:0xf bank_mask:0xf
    v_add_f32_dpp v9, v173, v9 quad_perm:[1,1,1,1] row_mask:0xf bank_mask:0xf
    v_add_f32_dpp v10, v177, v10 quad_perm:[1,1,1,1] row_mask:0xf bank_mask:0xf
    v_add_f32_dpp v11, v181, v11 quad_perm:[1,1,1,1] row_mask:0xf bank_mask:0xf
    v_add_f32_dpp v8, v170, v8 quad_perm:[2,2,2,2] row_mask:0xf bank_mask:0xf
    v_add_f32_dpp v9, v174, v9 quad_perm:[2,2,2,2] row_mask:0xf bank_mask:0xf
    v_add_f32_dpp v10, v178, v10 quad_perm:[2,2,2,2] row_mask:0xf bank_mask:0xf
    v_add_f32_dpp v11, v182, v11 quad_perm:[2,2,2,2] row_mask:0xf bank_mask:0xf
    v_add_f32_dpp v8, v171, v8 quad_perm:[3,3,3,3] row_mask:0xf bank_mask:0xf
    v_add_f32_dpp v9, v175, v9 quad_perm:[3,3,3,3] row_mask:0xf bank_mask:0xf
    v_add_f32_dpp v10, v179, v10 quad_perm:[3,3,3,3] row_mask:0xf bank_mask:0xf
    v_add_f32_dpp v11, v183, v11 quad_perm:[3,3,3,3] row_mask:0xf bank_mask:0xf
    v_cndmask_b32 v8, v8, v9, s[66:67]
    v_cndmask_b32 v10, v10, v11, s[66:67]
    v_cndmask_b32 v8, v8, v10, s[68:69]
    v_cvt_pk_bf16_f32 v8, v8, v8
    v_and_b32 v8, 0xffff0000, v8
    v_mul_f32 v8, 0x3db504f3, v8
    v_cvt_pk_bf16_f32 v8, v8, v8
    v_and_b32 v8, 0xffff0000, v8
    s_nop 1
    v_max_f32_dpp v9, v8, v8 quad_perm:[1,0,3,2] row_mask:0xf bank_mask:0xf
    s_nop 1
    v_max_f32_dpp v9, v9, v9 quad_perm:[2,3,0,1] row_mask:0xf bank_mask:0xf
    s_nop 1
    v_max_f32_dpp v9, v9, v9 row_ror:4 row_mask:0xf bank_mask:0xf
    s_nop 1
    v_max_f32_dpp v9, v9, v9 row_ror:8 row_mask:0xf bank_mask:0xf
    s_mov_b64 exec, s[56:57]
    ds_max_f32 v15, v9 offset:4608
    s_mov_b64 exec, -1
    s_waitcnt lgkmcnt(0)
    s_barrier
    ds_read_b32 v9, v15 offset:4608
    buffer_load_dwordx4 v[120:123], v2, s[40:43], s59 offen nt
    s_add_u32 s59, s59, 32768
    buffer_load_dwordx4 v[124:127], v2, s[40:43], s59 offen nt
    s_add_u32 s59, s59, 32768
    buffer_load_dwordx4 v[128:131], v2, s[40:43], s59 offen nt
    s_add_u32 s59, s59, 32768
    buffer_load_dwordx4 v[132:135], v2, s[40:43], s59 offen nt
    s_add_u32 s59, s59, 32768
    buffer_load_dwordx4 v[136:139], v2, s[40:43], s59 offen nt
    s_add_u32 s59, s59, 32768
    buffer_load_dwordx4 v[140:143], v2, s[40:43], s59 offen nt
    s_add_u32 s59, s59, 32768
    buffer_load_dwordx4 v[144:147], v2, s[40:43], s59 offen nt
    s_add_u32 s59, s59, 32768
    buffer_load_dwordx4 v[148:151], v2, s[40:43], s59 offen nt
    buffer_load_dwordx4 v[152:155], v3, s[48:51], s63 offen nt
    s_add_u32 s63, s63, 5120
    buffer_load_dwordx4 v[156:159], v3, s[48:51], s63 offen nt
    s_add_u32 s63, s63, 5120
    buffer_load_dwordx4 v[160:163], v3, s[48:51], s63 offen nt
    s_add_u32 s63, s63, 5120
    buffer_load_dwordx4 v[164:167], v3, s[48:51], s63 offen nt
    buffer_load_dwordx4 v[56:59], v3, s[44:47], s62 offen nt
    s_add_u32 s62, s62, 5120
    buffer_load_dwordx4 v[60:63], v3, s[44:47], s62 offen nt
    s_add_u32 s62, s62, 5120
    buffer_load_dwordx4 v[64:67], v3, s[44:47], s62 offen nt
    s_add_u32 s62, s62, 5120
    buffer_load_dwordx4 v[68:71], v3, s[44:47], s62 offen nt
    s_add_u32 s62, s62, 5120
    s_waitcnt lgkmcnt(0)
    v_sub_f32 v8, v8, v9
    v_mul_f32 v8, 0x3fb8aa3b, v8
    v_exp_f32 v8, v8
    s_nop 1
    v_add_f32_dpp v9, v8, v8 quad_perm:[1,0,3,2] row_mask:0xf bank_mask:0xf
    v_cvt_pk_bf16_f32 v10, v8, v8
    s_nop 0
    v_add_f32_dpp v9, v9, v9 quad_perm:[2,3,0,1] row_mask:0xf bank_mask:0xf
    v_mov_b32_dpp v11, v10 quad_perm:[0,0,1,1] row_mask:0xf bank_mask:0xf
    v_mov_b32_dpp v12, v10 quad_perm:[2,2,3,3] row_mask:0xf bank_mask:0xf
    v_add_f32_dpp v9, v9, v9 row_ror:4 row_mask:0xf bank_mask:0xf
    v_and_b32 v24, v11, v4
    v_and_b32_dpp v25, v11, v5 row_ror:4 row_mask:0xf bank_mask:0xf
    v_add_f32_dpp v9, v9, v9 row_ror:8 row_mask:0xf bank_mask:0xf
    s_mov_b64 exec, s[56:57]
    ds_add_f32 v15, v9 offset:4612
    s_mov_b64 exec, -1
    v_and_b32_dpp v26, v11, v6 row_ror:8 row_mask:0xf bank_mask:0xf
    v_and_b32_dpp v27, v11, v7 row_ror:12 row_mask:0xf bank_mask:0xf
    v_and_b32_dpp v28, v11, v4 row_ror:12 row_mask:0xf bank_mask:0xf
    v_and_b32 v29, v11, v5
    v_and_b32_dpp v30, v11, v6 row_ror:4 row_mask:0xf bank_mask:0xf
    v_and_b32_dpp v31, v11, v7 row_ror:8 row_mask:0xf bank_mask:0xf
    v_and_b32_dpp v32, v11, v4 row_ror:8 row_mask:0xf bank_mask:0xf
    v_and_b32_dpp v33, v11, v5 row_ror:12 row_mask:0xf bank_mask:0xf
    v_and_b32 v34, v11, v6
    v_and_b32_dpp v35, v11, v7 row_ror:4 row_mask:0xf bank_mask:0xf
    v_and_b32_dpp v36, v11, v4 row_ror:4 row_mask:0xf bank_mask:0xf
    v_and_b32_dpp v37, v11, v5 row_ror:8 row_mask:0xf bank_mask:0xf
    v_and_b32_dpp v38, v11, v6 row_ror:12 row_mask:0xf bank_mask:0xf
    v_and_b32 v39, v11, v7
    v_and_b32 v40, v12, v4
    v_and_b32_dpp v41, v12, v5 row_ror:4 row_mask:0xf bank_mask:0xf
    v_and_b32_dpp v42, v12, v6 row_ror:8 row_mask:0xf bank_mask:0xf
    v_and_b32_dpp v43, v12, v7 row_ror:12 row_mask:0xf bank_mask:0xf
    v_and_b32_dpp v44, v12, v4 row_ror:12 row_mask:0xf bank_mask:0xf
    v_and_b32 v45, v12, v5
    v_and_b32_dpp v46, v12, v6 row_ror:4 row_mask:0xf bank_mask:0xf
    v_and_b32_dpp v47, v12, v7 row_ror:8 row_mask:0xf bank_mask:0xf
    v_and_b32_dpp v48, v12, v4 row_ror:8 row_mask:0xf bank_mask:0xf
    v_and_b32_dpp v49, v12, v5 row_ror:12 row_mask:0xf bank_mask:0xf
    v_and_b32 v50, v12, v6
    v_and_b32_dpp v51, v12, v7 row_ror:4 row_mask:0xf bank_mask:0xf
    v_and_b32_dpp v52, v12, v4 row_ror:4 row_mask:0xf bank_mask:0xf
    v_and_b32_dpp v53, v12, v5 row_ror:8 row_mask:0xf bank_mask:0xf
    v_and_b32_dpp v54, v12, v6 row_ror:12 row_mask:0xf bank_mask:0xf
    v_and_b32 v55, v12, v7
    s_waitcnt vmcnt(23)
    v_mfma_f32_16x16x32_bf16 v[168:171], v[88:91], v[24:27], 0
    s_waitcnt vmcnt(22)
    v_mfma_f32_16x16x32_bf16 v[168:171], v[92:95], v[28:31], v[168:171]
    s_waitcnt vmcnt(21)
    v_mfma_f32_16x16x32_bf16 v[168:171], v[96:99], v[32:35], v[168:171]
    s_waitcnt vmcnt(20)
    v_mfma_f32_16x16x32_bf16 v[168:171], v[100:103], v[36:39], v[168:171]
    s_waitcnt vmcnt(19)
    v_mfma_f32_16x16x32_bf16 v[172:175], v[104:107], v[24:27], 0
    s_waitcnt vmcnt(18)
    v_mfma_f32_16x16x32_bf16 v[172:175], v[108:111], v[28:31], v[172:175]
    s_waitcnt vmcnt(17)
    v_mfma_f32_16x16x32_bf16 v[172:175], v[112:115], v[32:35], v[172:175]
    s_waitcnt vmcnt(16)
    v_mfma_f32_16x16x32_bf16 v[172:175], v[116:119], v[36:39], v[172:175]
    s_waitcnt vmcnt(15)
    v_mfma_f32_16x16x32_bf16 v[168:171], v[120:123], v[40:43], v[168:171]
    s_waitcnt vmcnt(14)
    v_mfma_f32_16x16x32_bf16 v[168:171], v[124:127], v[44:47], v[168:171]
    s_waitcnt vmcnt(13)
    v_mfma_f32_16x16x32_bf16 v[168:171], v[128:131], v[48:51], v[168:171]
    s_waitcnt vmcnt(12)
    v_mfma_f32_16x16x32_bf16 v[168:171], v[132:135], v[52:55], v[168:171]
    s_waitcnt vmcnt(11)
    v_mfma_f32_16x16x32_bf16 v[172:175], v[136:139], v[40:43], v[172:175]
    s_waitcnt vmcnt(10)
    v_mfma_f32_16x16x32_bf16 v[172:175], v[140:143], v[44:47], v[172:175]
    s_waitcnt vmcnt(9)
    v_mfma_f32_16x16x32_bf16 v[172:175], v[144:147], v[48:51], v[172:175]
    s_waitcnt vmcnt(8)
    v_mfma_f32_16x16x32_bf16 v[172:175], v[148:151], v[52:55], v[172:175]
    s_nop 7
    v_add_f32_dpp v168, v172, v168 quad_perm:[2,3,0,1] row_mask:0xf bank_mask:0xf
    v_add_f32_dpp v169, v173, v169 quad_perm:[2,3,0,1] row_mask:0xf bank_mask:0xf
    v_add_f32_dpp v170, v174, v170 quad_perm:[2,3,0,1] row_mask:0xf bank_mask:0xf
    v_add_f32_dpp v171, v175, v171 quad_perm:[2,3,0,1] row_mask:0xf bank_mask:0xf
    s_mov_b64 exec, s[70:71]
    ds_write_b128 v16, v[168:171] offset:0
    s_mov_b64 exec, -1
    s_waitcnt lgkmcnt(0)
    s_barrier
    s_barrier
    buffer_load_dwordx4 v[192:195], v20, s[32:35], s65 offen sc1
    buffer_load_dwordx4 v[196:199], v19, s[32:35], s64 offen sc1
    buffer_load_dwordx4 v[200:203], v19, s[32:35], s64 offen offset:128 sc1
    buffer_load_dwordx4 v[72:75], v3, s[44:47], s62 offen nt
    s_add_u32 s62, s62, 5120
    buffer_load_dwordx4 v[76:79], v3, s[44:47], s62 offen nt
    s_add_u32 s62, s62, 5120
    buffer_load_dwordx4 v[80:83], v3, s[44:47], s62 offen nt
    s_add_u32 s62, s62, 5120
    buffer_load_dwordx4 v[84:87], v3, s[44:47], s62 offen nt
    s_waitcnt vmcnt(14)
    v_mfma_f32_16x16x32_bf16 v[176:179], v[152:155], v[184:187], 0
    s_waitcnt vmcnt(13)
    v_mfma_f32_16x16x32_bf16 v[180:183], v[156:159], v[184:187], 0
    s_waitcnt vmcnt(12)
    v_mfma_f32_16x16x32_bf16 v[176:179], v[160:163], v[188:191], v[176:179]
    s_waitcnt vmcnt(11)
    v_mfma_f32_16x16x32_bf16 v[180:183], v[164:167], v[188:191], v[180:183]
    s_mov_b32 s7, 0
    s_add_u32 s7, s7, 1
    s_and_b32 s52, s7, 7
    s_cmp_eq_u32 s52, 7
    s_cselect_b32 s53, 0xfff00000, 0
    s_cmp_eq_u32 s52, 0
    s_cselect_b32 s53, 0x100000, s53
    s_add_u32 s64, s64, s53
    s_add_u32 s65, s65, s53
    s_cmp_gt_u32 s7, 100000
    s_cbranch_scc1 L_end
    s_waitcnt vmcnt(6)
    v_max_f32_dpp v8, v192, v192 quad_perm:[1,0,3,2] row_mask:0xf bank_mask:0xf
    v_min_u32 v14, v193, v195
    v_max_u32 v13, v193, v195
    v_max_f32_dpp v8, v8, v8 row_ror:4 row_mask:0xf bank_mask:0xf
    s_waitcnt vmcnt(5)
    v_min3_u32 v14, v197, v199, v14
    v_max3_u32 v13, v197, v199, v13
    v_max_f32_dpp v8, v8, v8 row_ror:8 row_mask:0xf bank_mask:0xf
    s_waitcnt vmcnt(4)
    v_min3_u32 v14, v201, v203, v14
    v_max3_u32 v13, v201, v203, v13
    v_sub_f32 v8, v192, v8
    v_cmp_eq_u32 vcc, s6, v14
    v_cmp_eq_u32 s[52:53], s6, v13
    v_mul_f32 v8, 0x3fb8aa3b, v8
    v_exp_f32 v8, v8
    s_and_b64 vcc, vcc, s[52:53]
    s_cmp_eq_u64 vcc, -1
    s_cbranch_scc1 L_h3ok
L_h3:
    buffer_load_dwordx4 v[192:195], v20, s[32:35], s65 offen sc1
    buffer_load_dwordx4 v[196:199], v19, s[32:35], s64 offen sc1
    buffer_load_dwordx4 v[200:203], v19, s[32:35], s64 offen offset:128 sc1
L_h3w:
    s_add_u32 s7, s7, 1
    s_and_b32 s52, s7, 7
    s_cmp_eq_u32 s52, 7
    s_cselect_b32 s53, 0xfff00000, 0
    s_cmp_eq_u32 s52, 0
    s_cselect_b32 s53, 0x100000, s53
    s_add_u32 s64, s64, s53
    s_add_u32 s65, s65, s53
    s_cmp_gt_u32 s7, 100000
    s_cbranch_scc1 L_end
    s_waitcnt vmcnt(2)
    v_max_f32_dpp v8, v192, v192 quad_perm:[1,0,3,2] row_mask:0xf bank_mask:0xf
    v_min_u32 v14, v193, v195
    v_max_u32 v13, v193, v195
    v_max_f32_dpp v8, v8, v8 row_ror:4 row_mask:0xf bank_mask:0xf
    s_waitcnt vmcnt(1)
    v_min3_u32 v14, v197, v199, v14
    v_max3_u32 v13, v197, v199, v13
    v_max_f32_dpp v8, v8, v8 row_ror:8 row_mask:0xf bank_mask:0xf
    s_waitcnt vmcnt(0)
    v_min3_u32 v14, v201, v203, v14
    v_max3_u32 v13, v201, v203, v13
    v_sub_f32 v8, v192, v8
    v_cmp_eq_u32 vcc, s6, v14
    v_cmp_eq_u32 s[52:53], s6, v13
    v_mul_f32 v8, 0x3fb8aa3b, v8
    v_exp_f32 v8, v8
    s_and_b64 vcc, vcc, s[52:53]
    s_cmp_eq_u64 vcc, -1
    s_cbranch_scc0 L_h3
L_h3ok:
    v_mul_f32 v13, v8, v194
    v_mul_f32 v9, v8, v196
    v_mul_f32 v10, v8, v198
    v_mul_f32 v11, v8, v200
    v_mul_f32 v12, v8, v202
    v_add_f32_dpp v13, v13, v13 quad_perm:[1,0,3,2] row_mask:0xf bank_mask:0xf
    v_add_f32_dpp v9, v9, v9 quad_perm:[1,0,3,2] row_mask:0xf bank_mask:0xf
    v_add_f32_dpp v10, v10, v10 quad_perm:[1,0,3,2] row_mask:0xf bank_mask:0xf
    v_add_f32_dpp v11, v11, v11 quad_perm:[1,0,3,2] row_mask:0xf bank_mask:0xf
    v_add_f32_dpp v12, v12, v12 quad_perm:[1,0,3,2] row_mask:0xf bank_mask:0xf
    v_add_f32_dpp v13, v13, v13 row_ror:4 row_mask:0xf bank_mask:0xf
    v_add_f32_dpp v9, v9, v9 row_ror:4 row_mask:0xf bank_mask:0xf
    v_add_f32_dpp v10, v10, v10 row_ror:4 row_mask:0xf bank_mask:0xf
    v_add_f32_dpp v11, v11, v11 row_ror:4 row_mask:0xf bank_mask:0xf
    v_add_f32_dpp v12, v12, v12 row_ror:4 row_mask:0xf bank_mask:0xf
    v_add_f32_dpp v13, v13, v13 row_ror:8 row_mask:0xf bank_mask:0xf
    v_rcp_f32 v13, v13
    v_add_f32_dpp v9, v9, v9 row_ror:8 row_mask:0xf bank_mask:0xf
    v_add_f32_dpp v10, v10, v10 row_ror:8 row_mask:0xf bank_mask:0xf
    v_add_f32_dpp v11, v11, v11 row_ror:8 row_mask:0xf bank_mask:0xf
    v_add_f32_dpp v12, v12, v12 row_ror:8 row_mask:0xf bank_mask:0xf
    v_mul_f32 v9, v9, v13
    v_mul_f32 v10, v10, v13
    v_mul_f32 v11, v11, v13
    v_mul_f32 v12, v12, v13
    v_cvt_pk_bf16_f32 v9, v9, v9
    v_cvt_pk_bf16_f32 v10, v10, v10
    v_cvt_pk_bf16_f32 v11, v11, v11
    v_cvt_pk_bf16_f32 v12, v12, v12
    v_and_b32 v88, v9, v4
    v_and_b32 v89, v9, v5
    v_and_b32 v90, v9, v6
    v_and_b32 v91, v9, v7
    v_and_b32 v92, v10, v4
    v_and_b32 v93, v10, v5
    v_and_b32 v94, v10, v6
    v_and_b32 v95, v10, v7
    v_mfma_f32_16x16x32_bf16 v[176:179], v[56:59], v[88:91], v[176:179]
    v_mfma_f32_16x16x32_bf16 v[180:183], v[60:63], v[88:91], v[180:183]
    v_and_b32 v96, v11, v4
    v_and_b32 v97, v11, v5
    v_and_b32 v98, v11, v6
    v_and_b32 v99, v11, v7
    v_mfma_f32_16x16x32_bf16 v[176:179], v[64:67], v[92:95], v[176:179]
    v_mfma_f32_16x16x32_bf16 v[180:183], v[68:71], v[92:95], v[180:183]
    v_and_b32 v100, v12, v4
    v_and_b32 v101, v12, v5
    v_and_b32 v102, v12, v6
    v_and_b32 v103, v12, v7
    s_waitcnt vmcnt(3)
    v_mfma_f32_16x16x32_bf16 v[176:179], v[72:75], v[96:99], v[176:179]
    s_waitcnt vmcnt(2)
    v_mfma_f32_16x16x32_bf16 v[180:183], v[76:79], v[96:99], v[180:183]
    s_waitcnt vmcnt(1)
    v_mfma_f32_16x16x32_bf16 v[176:179], v[80:83], v[100:103], v[176:179]
    s_waitcnt vmcnt(0)
    v_mfma_f32_16x16x32_bf16 v[180:183], v[84:87], v[100:103], v[180:183]
    s_nop 7
    v_add_f32_dpp v176, v180, v176 quad_perm:[2,3,0,1] row_mask:0xf bank_mask:0xf
    v_add_f32_dpp v177, v181, v177 quad_perm:[2,3,0,1] row_mask:0xf bank_mask:0xf
    v_add_f32_dpp v178, v182, v178 quad_perm:[2,3,0,1] row_mask:0xf bank_mask:0xf
    v_add_f32_dpp v179, v183, v179 quad_perm:[2,3,0,1] row_mask:0xf bank_mask:0xf
    s_mov_b64 exec, s[70:71]
    ds_write_b128 v16, v[176:179] offset:2048
    s_mov_b64 exec, -1
    s_waitcnt lgkmcnt(0)
    s_barrier
    s_endpgm
L_codeend:
.section .rodata,"a"
.p2align 6
.amdhsa_kernel parallel_sum__sliding_block_cached__dense_activation_gelu__decode_kernel
  .amdhsa_next_free_vgpr 204
  .amdhsa_next_free_sgpr 102
  .amdhsa_accum_offset 204
  .amdhsa_group_segment_fixed_size 0
  .amdhsa_kernarg_size 104
  .amdhsa_user_sgpr_count 2
  .amdhsa_user_sgpr_kernarg_segment_ptr 1
  .amdhsa_system_sgpr_workgroup_id_x 1
  .amdhsa_float_denorm_mode_32 3
.end_amdhsa_kernel
```
